```python
import torch

def _softmax(x, axis=-1):
    return torch.softmax(x, dim=axis)
def _gelu(x):
    return torch.nn.functional.gelu(x, approximate="tanh")
def _silu(x):
    return torch.nn.functional.silu(x)
def _sigmoid(x):
    return torch.sigmoid(x)
def _layernorm(x, axis=-1, eps=1e-5):
    m = x.mean(dim=axis, keepdim=True)
    v = x.var(dim=axis, keepdim=True, unbiased=False)
    return (x - m) / torch.sqrt(v + eps)
def _scatter_add(tgt, idx, src, axis=0):
    return tgt.clone().index_add_(axis, idx, src)
def _segment_sum(src, seg, n):
    out = torch.zeros((n,) + src.shape[1:], dtype=src.dtype)
    return out.index_add_(0, seg, src)
def _pad(x, pw):
    flat = tuple(v for pair in reversed(pw) for v in pair)
    return torch.nn.functional.pad(x, flat)

kernel_name = 'standalone__paged_block_table_kv_pagedattention__decode'

def setup_inputs():

    _w = (lambda a: (lambda t: t.to(torch.bfloat16) if t.is_floating_point() else t)(torch.as_tensor(a)))
    B, Hq, Hkv, Sq, Skv, D = 1, 16, 8, 1, 65536, 256
    bs = 16
    nbps = max(1, Skv // bs)
    num_phys = B * nbps + 4
    bt = torch.randperm(num_phys)[: B * nbps].reshape(B, nbps).to(torch.int64)
    cl = (nbps * bs - (torch.arange(1, B + 1, dtype=torch.int64) * 2654435761) % max(1, nbps * bs // 2)).to(torch.int64)
    return {
        "q": _w((lambda *s: torch.randn(*s, dtype=torch.bfloat16) * 0.8)(B, Hq, Sq, D)),
        "k_cache": _w((lambda *s: torch.randn(*s, dtype=torch.bfloat16) * 0.8)(num_phys, bs, Hkv, D)),
        "v_cache": _w((lambda *s: torch.randn(*s, dtype=torch.bfloat16) * 0.05)(num_phys, bs, Hkv, D)),
        "block_table": _w(bt),
        "context_lens": _w(cl),
    }

def reference(q, k_cache, v_cache, block_table, context_lens):
    B, Hq, Sq, D = q.shape
    bs = k_cache.shape[1]
    Hkv = k_cache.shape[2]
    nbps = block_table.shape[1]
    Skv = nbps * bs
    bt = block_table.reshape(-1)
    k = (lambda x, *d: x.permute(*d))(k_cache[bt].reshape(B, Skv, Hkv, D), 0, 2, 1, 3)
    v = (lambda x, *d: x.permute(*d))(v_cache[bt].reshape(B, Skv, Hkv, D), 0, 2, 1, 3)
    g = Hq // Hkv
    qg = q.reshape(B, Hkv, g, Sq, D)
    scores = torch.einsum("bhgqd,bhkd->bhgqk", qg, k) * (D ** -0.5)
    pos = torch.arange(Skv)
    msk = pos[None, :] < context_lens[:, None]
    scores = torch.where(msk[:, None, None, None, :], scores, -1e9)
    p = _softmax(scores, axis=-1)
    out = torch.einsum("bhgqk,bhkd->bhgqd", p, v)
    return out.reshape(B, Hq, Sq, D)
```

```asm
; @launch grid=(256,1,1) block=(256,1,1) lds=16448
.amdgcn_target "amdgcn-amd-amdhsa--gfx950"
.text
.globl standalone__paged_block_table_kv_pagedattention__decode_kernel
.p2align 8
.type standalone__paged_block_table_kv_pagedattention__decode_kernel,@function
standalone__paged_block_table_kv_pagedattention__decode_kernel:
    s_load_dwordx8 s[4:11], s[0:1], 0
    s_load_dwordx8 s[12:19], s[0:1], 32
    s_getpc_b64 s[86:87]
L_pc:
    v_lshlrev_b32 v6, 7, v0
    v_min_u32 v6, L_end-L_pc, v6
    global_load_dword v199, v6, s[86:87]
    v_readfirstlane_b32 s29, v0
    s_cmp_ge_u32 s2, 256
    s_cbranch_scc1 L_end
    s_and_b32 s31, s2, 31
    s_lshl_b32 s34, s29, 1
    s_lshl2_add_u32 s34, s31, s34
    s_waitcnt lgkmcnt(0)
    s_load_dword s43, s[10:11], s34
    s_load_dword s28, s[12:13], 0
    v_and_b32 v1, 63, v0
    s_lshr_b32 s30, s2, 5
    s_lshr_b32 s29, s29, 6
    s_lshr_b32 s32, s34, 2
    v_and_b32 v10, 15, v1
    v_lshrrev_b32 v11, 4, v1
    s_lshl_b32 s41, s30, 9
    v_and_b32 v2, 7, v1
    v_lshlrev_b32 v2, 12, v2
    v_bfe_u32 v3, v1, 3, 1
    v_lshl_add_u32 v2, v3, 6, v2
    v_lshl_add_u32 v2, v11, 4, v2
    v_add_u32 v2, s41, v2
    v_add_u32 v3, 0x8000, v2
    s_mov_b32 s20, s6
    s_and_b32 s21, s7, 0xffff
    s_mov_b32 s22, 268697600
    s_mov_b32 s23, 0x20000
    s_lshl_b32 s40, s31, 2
    v_lshl_add_u32 v6, v10, 9, s40
    v_lshl_add_u32 v6, v11, 7, v6
    v_add_u32 v7, 0x2000, v6
    global_load_dword v196, v6, s[10:11]
    global_load_dword v197, v7, s[10:11]
    v_bfe_u32 v15, v1, 1, 1
    v_lshlrev_b32 v12, 9, v15
    v_lshl_add_u32 v12, v11, 4, v12
    v_and_b32 v14, 1, v1
    v_lshl_add_u32 v12, v14, 6, v12
    s_lshl_b32 s42, s30, 10
    v_add_u32 v12, s42, v12
    global_load_dwordx4 v[72:75], v12, s[4:5] offset:0
    global_load_dwordx4 v[76:79], v12, s[4:5] offset:128
    global_load_dwordx4 v[80:83], v12, s[4:5] offset:256
    global_load_dwordx4 v[84:87], v12, s[4:5] offset:384
    s_waitcnt lgkmcnt(0)
    s_lshl_b32 s43, s43, 16
    s_mov_b32 s58, s43
    s_cmp_lt_i32 s28, 1
    s_cselect_b32 s36, 0, 0x3db8aa3b
    s_cselect_b32 s28, 0x10000, s28
    s_min_i32 s28, s28, 0x10000
    s_sub_u32 s33, s28, 1
    s_lshr_b32 s33, s33, 11
    s_cbranch_scc0 L_skip0
    buffer_load_dwordx4 v[100:103], v2, s[20:23], s43 offen offset:0 nt
    buffer_load_dwordx4 v[104:107], v3, s[20:23], s43 offen offset:128 nt
    buffer_load_dwordx4 v[108:111], v2, s[20:23], s43 offen offset:256 nt
    buffer_load_dwordx4 v[112:115], v3, s[20:23], s43 offen offset:384 nt
    buffer_load_dwordx4 v[116:119], v2, s[20:23], s43 offen offset:128 nt
    buffer_load_dwordx4 v[120:123], v3, s[20:23], s43 offen offset:0 nt
    buffer_load_dwordx4 v[124:127], v2, s[20:23], s43 offen offset:384 nt
L_skip0:
    s_mov_b32 s24, s8
    s_and_b32 s25, s9, 0xffff
    s_mov_b32 s26, s22
    s_mov_b32 s27, 0x20000
    s_mov_b32 s78, s33
    s_lshl_b32 s40, s33, 11
    s_sub_u32 s40, s28, s40
    s_mul_i32 s45, s40, s32
    s_add_u32 s35, s45, s40
    s_lshr_b32 s45, s45, 7
    s_lshr_b32 s35, s35, 7
    s_sub_u32 s35, s35, s45
    s_lshr_b32 s40, s45, 4
    s_lshl_b32 s54, s33, 7
    s_add_u32 s40, s40, s54
    s_lshl_b32 s40, s40, 2
    s_and_b32 s40, s40, 0x3ffc
    s_add_u32 s44, s40, 4
    s_and_b32 s44, s44, 0x3ffc
    s_load_dword s54, s[10:11], s40
    s_load_dword s55, s[10:11], s44
    s_and_b32 s45, s45, 15
    s_memrealtime s[50:51]
    s_mov_b32 s59, s33
    s_mov_b32 s39, 0
    v_mov_b32 v7, 1
    v_mov_b32 v198, 0
    s_waitcnt vmcnt(11)
L_sort:
    v_cmp_gt_i32 vcc, s59, v10
    v_mov_b32 v17, 0x800000
    v_and_b32 v16, 0xffff, v196
    v_add_u32 v16, 2, v16
    v_cndmask_b32 v16, v17, v16, vcc
    v_cmp_le_u32 vcc, v7, v10
    v_lshlrev_b32 v196, 16, v196
    v_mov_b32 v7, 0
    v_cndmask_b32 v16, v10, v16, vcc
    v_lshl_or_b32 v16, v16, 6, v1
    v_mov_b32 v20, v16
    v_mov_b32 v21, v16
    s_nop 1
    v_permlane16_swap_b32 v20, v21
    v_mov_b32 v22, v20
    v_mov_b32 v23, v21
    s_nop 0
    v_permlane32_swap_b32 v20, v22
    v_permlane32_swap_b32 v21, v23
    v_sub_u32 v17, v20, v16
    v_alignbit_b32 v18, v18, v17, 31
    v_sub_u32_dpp v17, v20, v16 row_ror:1 row_mask:0xf bank_mask:0xf
    v_alignbit_b32 v18, v18, v17, 31
    v_sub_u32_dpp v17, v20, v16 row_ror:2 row_mask:0xf bank_mask:0xf
    v_alignbit_b32 v18, v18, v17, 31
    v_sub_u32_dpp v17, v20, v16 row_ror:3 row_mask:0xf bank_mask:0xf
    v_alignbit_b32 v18, v18, v17, 31
    v_sub_u32_dpp v17, v20, v16 row_ror:4 row_mask:0xf bank_mask:0xf
    v_alignbit_b32 v18, v18, v17, 31
    v_sub_u32_dpp v17, v20, v16 row_ror:5 row_mask:0xf bank_mask:0xf
    v_alignbit_b32 v18, v18, v17, 31
    v_sub_u32_dpp v17, v20, v16 row_ror:6 row_mask:0xf bank_mask:0xf
    v_alignbit_b32 v18, v18, v17, 31
    v_sub_u32_dpp v17, v20, v16 row_ror:7 row_mask:0xf bank_mask:0xf
    v_alignbit_b32 v18, v18, v17, 31
    v_sub_u32_dpp v17, v20, v16 row_ror:8 row_mask:0xf bank_mask:0xf
    v_alignbit_b32 v18, v18, v17, 31
    v_sub_u32_dpp v17, v20, v16 row_ror:9 row_mask:0xf bank_mask:0xf
    v_alignbit_b32 v18, v18, v17, 31
    v_sub_u32_dpp v17, v20, v16 row_ror:10 row_mask:0xf bank_mask:0xf
    v_alignbit_b32 v18, v18, v17, 31
    v_sub_u32_dpp v17, v20, v16 row_ror:11 row_mask:0xf bank_mask:0xf
    v_alignbit_b32 v18, v18, v17, 31
    v_sub_u32_dpp v17, v20, v16 row_ror:12 row_mask:0xf bank_mask:0xf
    v_alignbit_b32 v18, v18, v17, 31
    v_sub_u32_dpp v17, v20, v16 row_ror:13 row_mask:0xf bank_mask:0xf
    v_alignbit_b32 v18, v18, v17, 31
    v_sub_u32_dpp v17, v20, v16 row_ror:14 row_mask:0xf bank_mask:0xf
    v_alignbit_b32 v18, v18, v17, 31
    v_sub_u32_dpp v17, v20, v16 row_ror:15 row_mask:0xf bank_mask:0xf
    v_alignbit_b32 v18, v18, v17, 31
    v_sub_u32 v17, v21, v16
    v_alignbit_b32 v18, v18, v17, 31
    v_sub_u32_dpp v17, v21, v16 row_ror:1 row_mask:0xf bank_mask:0xf
    v_alignbit_b32 v18, v18, v17, 31
    v_sub_u32_dpp v17, v21, v16 row_ror:2 row_mask:0xf bank_mask:0xf
    v_alignbit_b32 v18, v18, v17, 31
    v_sub_u32_dpp v17, v21, v16 row_ror:3 row_mask:0xf bank_mask:0xf
    v_alignbit_b32 v18, v18, v17, 31
    v_sub_u32_dpp v17, v21, v16 row_ror:4 row_mask:0xf bank_mask:0xf
    v_alignbit_b32 v18, v18, v17, 31
    v_sub_u32_dpp v17, v21, v16 row_ror:5 row_mask:0xf bank_mask:0xf
    v_alignbit_b32 v18, v18, v17, 31
    v_sub_u32_dpp v17, v21, v16 row_ror:6 row_mask:0xf bank_mask:0xf
    v_alignbit_b32 v18, v18, v17, 31
    v_sub_u32_dpp v17, v21, v16 row_ror:7 row_mask:0xf bank_mask:0xf
    v_alignbit_b32 v18, v18, v17, 31
    v_sub_u32_dpp v17, v21, v16 row_ror:8 row_mask:0xf bank_mask:0xf
    v_alignbit_b32 v18, v18, v17, 31
    v_sub_u32_dpp v17, v21, v16 row_ror:9 row_mask:0xf bank_mask:0xf
    v_alignbit_b32 v18, v18, v17, 31
    v_sub_u32_dpp v17, v21, v16 row_ror:10 row_mask:0xf bank_mask:0xf
    v_alignbit_b32 v18, v18, v17, 31
    v_sub_u32_dpp v17, v21, v16 row_ror:11 row_mask:0xf bank_mask:0xf
    v_alignbit_b32 v18, v18, v17, 31
    v_sub_u32_dpp v17, v21, v16 row_ror:12 row_mask:0xf bank_mask:0xf
    v_alignbit_b32 v18, v18, v17, 31
    v_sub_u32_dpp v17, v21, v16 row_ror:13 row_mask:0xf bank_mask:0xf
    v_alignbit_b32 v18, v18, v17, 31
    v_sub_u32_dpp v17, v21, v16 row_ror:14 row_mask:0xf bank_mask:0xf
    v_alignbit_b32 v18, v18, v17, 31
    v_sub_u32_dpp v17, v21, v16 row_ror:15 row_mask:0xf bank_mask:0xf
    v_alignbit_b32 v18, v18, v17, 31
    v_sub_u32 v17, v22, v16
    v_alignbit_b32 v19, v19, v17, 31
    v_sub_u32_dpp v17, v22, v16 row_ror:1 row_mask:0xf bank_mask:0xf
    v_alignbit_b32 v19, v19, v17, 31
    v_sub_u32_dpp v17, v22, v16 row_ror:2 row_mask:0xf bank_mask:0xf
    v_alignbit_b32 v19, v19, v17, 31
    v_sub_u32_dpp v17, v22, v16 row_ror:3 row_mask:0xf bank_mask:0xf
    v_alignbit_b32 v19, v19, v17, 31
    v_sub_u32_dpp v17, v22, v16 row_ror:4 row_mask:0xf bank_mask:0xf
    v_alignbit_b32 v19, v19, v17, 31
    v_sub_u32_dpp v17, v22, v16 row_ror:5 row_mask:0xf bank_mask:0xf
    v_alignbit_b32 v19, v19, v17, 31
    v_sub_u32_dpp v17, v22, v16 row_ror:6 row_mask:0xf bank_mask:0xf
    v_alignbit_b32 v19, v19, v17, 31
    v_sub_u32_dpp v17, v22, v16 row_ror:7 row_mask:0xf bank_mask:0xf
    v_alignbit_b32 v19, v19, v17, 31
    v_sub_u32_dpp v17, v22, v16 row_ror:8 row_mask:0xf bank_mask:0xf
    v_alignbit_b32 v19, v19, v17, 31
    v_sub_u32_dpp v17, v22, v16 row_ror:9 row_mask:0xf bank_mask:0xf
    v_alignbit_b32 v19, v19, v17, 31
    v_sub_u32_dpp v17, v22, v16 row_ror:10 row_mask:0xf bank_mask:0xf
    v_alignbit_b32 v19, v19, v17, 31
    v_sub_u32_dpp v17, v22, v16 row_ror:11 row_mask:0xf bank_mask:0xf
    v_alignbit_b32 v19, v19, v17, 31
    v_sub_u32_dpp v17, v22, v16 row_ror:12 row_mask:0xf bank_mask:0xf
    v_alignbit_b32 v19, v19, v17, 31
    v_sub_u32_dpp v17, v22, v16 row_ror:13 row_mask:0xf bank_mask:0xf
    v_alignbit_b32 v19, v19, v17, 31
    v_sub_u32_dpp v17, v22, v16 row_ror:14 row_mask:0xf bank_mask:0xf
    v_alignbit_b32 v19, v19, v17, 31
    v_sub_u32_dpp v17, v22, v16 row_ror:15 row_mask:0xf bank_mask:0xf
    v_alignbit_b32 v19, v19, v17, 31
    v_sub_u32 v17, v23, v16
    v_alignbit_b32 v19, v19, v17, 31
    v_sub_u32_dpp v17, v23, v16 row_ror:1 row_mask:0xf bank_mask:0xf
    v_alignbit_b32 v19, v19, v17, 31
    v_sub_u32_dpp v17, v23, v16 row_ror:2 row_mask:0xf bank_mask:0xf
    v_alignbit_b32 v19, v19, v17, 31
    v_sub_u32_dpp v17, v23, v16 row_ror:3 row_mask:0xf bank_mask:0xf
    v_alignbit_b32 v19, v19, v17, 31
    v_sub_u32_dpp v17, v23, v16 row_ror:4 row_mask:0xf bank_mask:0xf
    v_alignbit_b32 v19, v19, v17, 31
    v_sub_u32_dpp v17, v23, v16 row_ror:5 row_mask:0xf bank_mask:0xf
    v_alignbit_b32 v19, v19, v17, 31
    v_sub_u32_dpp v17, v23, v16 row_ror:6 row_mask:0xf bank_mask:0xf
    v_alignbit_b32 v19, v19, v17, 31
    v_sub_u32_dpp v17, v23, v16 row_ror:7 row_mask:0xf bank_mask:0xf
    v_alignbit_b32 v19, v19, v17, 31
    v_sub_u32_dpp v17, v23, v16 row_ror:8 row_mask:0xf bank_mask:0xf
    v_alignbit_b32 v19, v19, v17, 31
    v_sub_u32_dpp v17, v23, v16 row_ror:9 row_mask:0xf bank_mask:0xf
    v_alignbit_b32 v19, v19, v17, 31
    v_sub_u32_dpp v17, v23, v16 row_ror:10 row_mask:0xf bank_mask:0xf
    v_alignbit_b32 v19, v19, v17, 31
    v_sub_u32_dpp v17, v23, v16 row_ror:11 row_mask:0xf bank_mask:0xf
    v_alignbit_b32 v19, v19, v17, 31
    v_sub_u32_dpp v17, v23, v16 row_ror:12 row_mask:0xf bank_mask:0xf
    v_alignbit_b32 v19, v19, v17, 31
    v_sub_u32_dpp v17, v23, v16 row_ror:13 row_mask:0xf bank_mask:0xf
    v_alignbit_b32 v19, v19, v17, 31
    v_sub_u32_dpp v17, v23, v16 row_ror:14 row_mask:0xf bank_mask:0xf
    v_alignbit_b32 v19, v19, v17, 31
    v_sub_u32_dpp v17, v23, v16 row_ror:15 row_mask:0xf bank_mask:0xf
    v_alignbit_b32 v19, v19, v17, 31
    v_bcnt_u32_b32 v18, v18, 0
    v_bcnt_u32_b32 v18, v19, v18
    v_and_b32 v17, 3, v18
    v_cmp_eq_u32 vcc, s29, v17
    v_and_b32 v18, 60, v18
    v_add_u32 v18, s39, v18
    v_mov_b32 v17, 0xfc
    v_cndmask_b32 v18, v17, v18, vcc
    ds_permute_b32 v17, v18, v196
    v_mov_b32 v196, v197
    s_sub_i32 s59, s59, 16
    s_add_u32 s39, s39, 64
    s_cmp_gt_i32 s59, 0
    s_waitcnt lgkmcnt(0)
    v_or_b32 v198, v198, v17
    s_cbranch_scc1 L_sort
    v_mov_b32 v196, v198
    s_mov_b32 s34, 1
    v_mov_b32 v8, 0xff7fffff
    s_lshl_b32 s79, s29, 12
    v_lshl_add_u32 v96, v11, 5, s79
    v_lshl_add_u32 v96, v15, 4, v96
    s_mov_b32 s56, 0x00050005
    s_mov_b32 s57, 0x00050005
    v_mov_b32 v99, 0
    s_waitcnt lgkmcnt(0)
    s_bitset1_b32 s51, 31
    s_bitset0_b32 s50, 31
    v_mov_b32 v164, s50
    v_mov_b32 v165, s51
    v_mov_b32 v166, 0
    v_mov_b32 v167, 0
    s_lshl_b32 s40, s2, 2
    s_add_u32 s40, s40, s29
    s_cmp_lg_u32 s40, 1023
    s_cbranch_scc1 L_nononce
    s_mov_b64 exec, 1
    global_atomic_cmpswap_x2 v99, v[164:167], s[16:17]
    s_mov_b64 exec, -1
L_nononce:
    s_lshl_b32 s40, s45, 12
    s_lshl_b32 s54, s54, 16
    s_add_u32 s54, s54, s40
    s_sub_u32 s55, s55, 1
    s_lshl_b32 s55, s55, 16
    s_add_u32 s55, s55, s40
    s_sub_u32 s45, 16, s45
    v_mov_b32 v172, s54
    v_mov_b32 v173, s55
    v_bfrev_b32 v174, 1
    v_bfe_u32 v6, v2, 12, 4
    v_cmp_le_u32 vcc, s45, v6
    v_cmp_gt_u32 s[82:83], s35, v6
    s_nop 0
    v_cndmask_b32 v168, v172, v173, vcc
    v_add_u32 v168, v168, v2
    v_cndmask_b32 v168, v174, v168, s[82:83]
    v_bfe_u32 v6, v3, 12, 4
    v_cmp_le_u32 vcc, s45, v6
    v_cmp_gt_u32 s[82:83], s35, v6
    s_nop 0
    v_cndmask_b32 v169, v172, v173, vcc
    v_add_u32 v169, v169, v3
    v_cndmask_b32 v169, v174, v169, s[82:83]
    s_cmp_lg_u32 s33, 0
    s_cbranch_scc1 L_k0
    v_mov_b32 v2, v168
    v_mov_b32 v3, v169
    s_mov_b32 s43, 0
    buffer_load_dwordx4 v[100:103], v2, s[20:23], s43 offen offset:0 nt
    buffer_load_dwordx4 v[104:107], v3, s[20:23], s43 offen offset:128 nt
    buffer_load_dwordx4 v[108:111], v2, s[20:23], s43 offen offset:256 nt
    buffer_load_dwordx4 v[112:115], v3, s[20:23], s43 offen offset:384 nt
    buffer_load_dwordx4 v[116:119], v2, s[20:23], s43 offen offset:128 nt
    buffer_load_dwordx4 v[120:123], v3, s[20:23], s43 offen offset:0 nt
    buffer_load_dwordx4 v[124:127], v2, s[20:23], s43 offen offset:384 nt
    s_waitcnt vmcnt(6)
    v_mfma_f32_16x16x32_bf16 v[16:19], v[100:103], v[72:75], 0
    s_branch L_klast
L_k0:
    s_waitcnt vmcnt(6)
    v_mfma_f32_16x16x32_bf16 v[16:19], v[100:103], v[72:75], 0
L_kloop:
    v_readlane_b32 s44, v196, s34
    s_add_u32 s34, s34, 1
    s_waitcnt vmcnt(5)
    v_mfma_f32_16x16x32_bf16 v[20:23], v[104:107], v[76:79], 0
    s_waitcnt vmcnt(4)
    buffer_load_dwordx4 v[128:131], v3, s[20:23], s43 offen offset:256 nt
    s_cmp_lg_u32 s33, 1
    s_cbranch_scc1 L_knotpen
    v_mov_b32 v2, v168
    v_mov_b32 v3, v169
    s_mov_b32 s44, 0
L_knotpen:
    buffer_load_dwordx4 v[100:103], v2, s[20:23], s44 offen offset:0 nt
    v_mfma_f32_16x16x32_bf16 v[16:19], v[108:111], v[80:83], v[16:19]
    s_waitcnt vmcnt(5)
    v_mfma_f32_16x16x32_bf16 v[20:23], v[112:115], v[84:87], v[20:23]
    s_waitcnt vmcnt(4)
    buffer_load_dwordx4 v[104:107], v3, s[20:23], s44 offen offset:128 nt
    buffer_load_dwordx4 v[108:111], v2, s[20:23], s44 offen offset:256 nt
    v_mfma_f32_16x16x32_bf16 v[16:19], v[116:119], v[76:79], v[16:19]
    s_waitcnt vmcnt(5)
    v_mfma_f32_16x16x32_bf16 v[20:23], v[120:123], v[72:75], v[20:23]
    s_waitcnt vmcnt(4)
    buffer_load_dwordx4 v[112:115], v3, s[20:23], s44 offen offset:384 nt
    buffer_load_dwordx4 v[116:119], v2, s[20:23], s44 offen offset:128 nt
    v_mfma_f32_16x16x32_bf16 v[16:19], v[124:127], v[84:87], v[16:19]
    s_waitcnt vmcnt(5)
    v_mfma_f32_16x16x32_bf16 v[20:23], v[128:131], v[80:83], v[20:23]
    s_waitcnt vmcnt(4)
    buffer_load_dwordx4 v[120:123], v3, s[20:23], s44 offen offset:0 nt
    buffer_load_dwordx4 v[124:127], v2, s[20:23], s44 offen offset:384 nt
    s_mov_b32 s43, s44
    s_sub_u32 s33, s33, 1
    s_cmp_lg_u32 s33, 0
    s_nop 1
    v_permlane32_swap_b32 v16, v20
    v_permlane32_swap_b32 v17, v21
    v_permlane32_swap_b32 v18, v22
    v_permlane32_swap_b32 v19, v23
    v_mov_b32_dpp v20, v20 quad_perm:[1,1,3,3] row_mask:0xf bank_mask:0xf
    v_mov_b32_dpp v21, v21 quad_perm:[1,1,3,3] row_mask:0xf bank_mask:0xf
    v_mov_b32_dpp v22, v22 quad_perm:[1,1,3,3] row_mask:0xf bank_mask:0xf
    v_mov_b32_dpp v23, v23 quad_perm:[1,1,3,3] row_mask:0xf bank_mask:0xf
    v_add_f32_dpp v192, v16, v20 quad_perm:[0,0,2,2] row_mask:0xf bank_mask:0xf
    v_add_f32_dpp v193, v17, v21 quad_perm:[0,0,2,2] row_mask:0xf bank_mask:0xf
    v_add_f32_dpp v194, v18, v22 quad_perm:[0,0,2,2] row_mask:0xf bank_mask:0xf
    v_add_f32_dpp v195, v19, v23 quad_perm:[0,0,2,2] row_mask:0xf bank_mask:0xf
    s_mov_b64 exec, s[56:57]
    ds_write_b128 v96, v[192:195]
    s_mov_b64 exec, -1
    v_max3_f32 v8, v8, v192, v193
    v_add_u32 v96, 0x80, v96
    v_max3_f32 v8, v8, v194, v195
    v_mfma_f32_16x16x32_bf16 v[16:19], v[100:103], v[72:75], 0
    s_cbranch_scc1 L_kloop
L_klast:
    s_load_dwordx2 s[52:53], s[16:17], 0
    v_lshrrev_b32 v12, 3, v1
    v_and_b32 v13, 7, v1
    v_lshlrev_b32 v4, 12, v12
    v_lshl_add_u32 v4, v13, 4, v4
    v_add_u32 v4, s41, v4
    v_add_u32 v5, 0x8000, v4
    v_bfe_u32 v6, v4, 12, 4
    v_cmp_le_u32 vcc, s45, v6
    v_cmp_gt_u32 s[82:83], s35, v6
    s_nop 0
    v_cndmask_b32 v170, v172, v173, vcc
    v_add_u32 v170, v170, v4
    v_cndmask_b32 v170, v174, v170, s[82:83]
    v_bfe_u32 v6, v5, 12, 4
    v_cmp_le_u32 vcc, s45, v6
    v_cmp_gt_u32 s[82:83], s35, v6
    s_nop 0
    v_cndmask_b32 v171, v172, v173, vcc
    v_add_u32 v171, v171, v5
    v_cndmask_b32 v171, v174, v171, s[82:83]
    s_cmp_lg_u32 s78, 0
    s_cbranch_scc1 L_vnorm
    v_mov_b32 v4, v170
    v_mov_b32 v5, v171
    s_mov_b32 s58, 0
L_vnorm:
    s_waitcnt vmcnt(5)
    v_mfma_f32_16x16x32_bf16 v[20:23], v[104:107], v[76:79], 0
    s_waitcnt vmcnt(4)
    buffer_load_dwordx4 v[128:131], v3, s[20:23], s43 offen offset:256 nt
    buffer_load_dwordx4 v[132:135], v4, s[24:27], s58 offen offset:0 nt
    v_mfma_f32_16x16x32_bf16 v[16:19], v[108:111], v[80:83], v[16:19]
    v_and_b32 v6, 5, v1
    v_cmp_eq_u32 vcc, 0, v6
    v_mov_b32 v200, 0
    v_mov_b32 v201, 0
    v_cndmask_b32 v24, 0, -1, vcc
    v_cmp_eq_u32 vcc, 1, v6
    v_mov_b32 v202, 0
    v_mov_b32 v203, 0
    v_cndmask_b32 v25, 0, -1, vcc
    v_cmp_eq_u32 vcc, 4, v6
    v_mov_b32 v204, 0
    v_mov_b32 v205, 0
    v_cndmask_b32 v26, 0, -1, vcc
    v_cmp_eq_u32 vcc, 5, v6
    v_mov_b32 v206, 0
    v_mov_b32 v207, 0
    v_cndmask_b32 v27, 0, -1, vcc
    s_waitcnt vmcnt(5)
    v_mfma_f32_16x16x32_bf16 v[20:23], v[112:115], v[84:87], v[20:23]
    s_waitcnt vmcnt(4)
    buffer_load_dwordx4 v[136:139], v5, s[24:27], s58 offen offset:128 nt
    buffer_load_dwordx4 v[140:143], v4, s[24:27], s58 offen offset:256 nt
    v_mfma_f32_16x16x32_bf16 v[16:19], v[116:119], v[76:79], v[16:19]
    v_mov_b32 v208, 0
    v_mov_b32 v209, 0
    v_mov_b32 v210, 0
    v_mov_b32 v211, 0
    v_mov_b32 v212, 0
    v_mov_b32 v213, 0
    v_mov_b32 v214, 0
    v_mov_b32 v215, 0
    v_mov_b32 v216, 0
    v_mov_b32 v217, 0
    v_mov_b32 v218, 0
    v_mov_b32 v219, 0
    v_mov_b32 v220, 0
    v_mov_b32 v221, 0
    v_mov_b32 v222, 0
    v_mov_b32 v223, 0
    s_waitcnt vmcnt(5)
    v_mfma_f32_16x16x32_bf16 v[20:23], v[120:123], v[72:75], v[20:23]
    s_waitcnt vmcnt(4)
    buffer_load_dwordx4 v[144:147], v5, s[24:27], s58 offen offset:384 nt
    buffer_load_dwordx4 v[148:151], v4, s[24:27], s58 offen offset:128 nt
    v_mfma_f32_16x16x32_bf16 v[16:19], v[124:127], v[84:87], v[16:19]
    v_mov_b32 v224, 0
    v_mov_b32 v225, 0
    v_mov_b32 v226, 0
    v_mov_b32 v227, 0
    v_mov_b32 v228, 0
    v_mov_b32 v229, 0
    v_mov_b32 v230, 0
    v_mov_b32 v231, 0
    v_lshlrev_b32 v88, 2, v11
    s_mov_b32 s37, 0x05040100
    s_mov_b32 s38, 0x07060302
    v_mov_b32 v9, 0
    v_lshrrev_b32 v6, 2, v12
    v_lshl_add_u32 v97, v6, 5, s79
    v_lshl_add_u32 v97, v15, 4, v97
    v_and_b32 v6, 3, v12
    v_lshl_add_u32 v97, v6, 2, v97
    s_waitcnt vmcnt(5)
    v_mfma_f32_16x16x32_bf16 v[20:23], v[128:131], v[80:83], v[20:23]
    s_mov_b32 s43, s58
    s_mov_b32 s33, s78
    s_mov_b32 s34, 1
    s_nop 4
    v_permlane32_swap_b32 v16, v20
    v_permlane32_swap_b32 v17, v21
    v_permlane32_swap_b32 v18, v22
    v_permlane32_swap_b32 v19, v23
    v_mov_b32_dpp v20, v20 quad_perm:[1,1,3,3] row_mask:0xf bank_mask:0xf
    v_mov_b32_dpp v21, v21 quad_perm:[1,1,3,3] row_mask:0xf bank_mask:0xf
    v_mov_b32_dpp v22, v22 quad_perm:[1,1,3,3] row_mask:0xf bank_mask:0xf
    v_mov_b32_dpp v23, v23 quad_perm:[1,1,3,3] row_mask:0xf bank_mask:0xf
    v_add_f32_dpp v192, v16, v20 quad_perm:[0,0,2,2] row_mask:0xf bank_mask:0xf
    v_add_f32_dpp v193, v17, v21 quad_perm:[0,0,2,2] row_mask:0xf bank_mask:0xf
    v_add_f32_dpp v194, v18, v22 quad_perm:[0,0,2,2] row_mask:0xf bank_mask:0xf
    v_add_f32_dpp v195, v19, v23 quad_perm:[0,0,2,2] row_mask:0xf bank_mask:0xf
    v_mov_b32 v11, 0xff800000
    v_cmp_gt_i32 vcc, s35, v88
    s_sub_u32 s35, s35, 1
    s_nop 0
    v_cndmask_b32 v192, v11, v192, vcc
    v_cmp_gt_i32 vcc, s35, v88
    s_sub_u32 s35, s35, 1
    s_nop 0
    v_cndmask_b32 v193, v11, v193, vcc
    v_cmp_gt_i32 vcc, s35, v88
    s_sub_u32 s35, s35, 1
    s_nop 0
    v_cndmask_b32 v194, v11, v194, vcc
    v_cmp_gt_i32 vcc, s35, v88
    s_sub_u32 s35, s35, 1
    s_nop 0
    v_cndmask_b32 v195, v11, v195, vcc
    s_mov_b64 exec, s[56:57]
    ds_write_b128 v96, v[192:195]
    s_mov_b64 exec, -1
    v_max3_f32 v8, v8, v192, v193
    v_add_u32 v96, 0x80, v96
    v_max3_f32 v8, v8, v194, v195
    ds_read2_b32 v[16:17], v97 offset0:0 offset1:16
    v_mov_b32 v11, v8
    v_add_u32 v97, 0x80, v97
    s_nop 0
    v_permlane32_swap_b32 v8, v11
    v_max_f32 v8, v8, v11
    v_mov_b32 v11, v8
    s_nop 1
    v_permlane16_swap_b32 v8, v11
    v_max_f32 v8, v8, v11
    v_mul_f32 v8, s36, v8
    v_max_f32 v8, 0xf149f2ca, v8
    s_cmp_eq_u32 s33, 0
    s_cbranch_scc0 L_vnz
    s_waitcnt lgkmcnt(0)
    v_mov_b32 v16, 0xff800000
    v_mov_b32 v17, 0xff800000
    v_subrev_u32 v97, 0x80, v97
L_vnz:
    s_cmp_le_u32 s33, 1
    s_cbranch_scc1 L_vpen
L_vloop:
    v_readlane_b32 s44, v196, s34
    s_add_u32 s34, s34, 1
    s_waitcnt lgkmcnt(0)
    v_fma_f32 v192, v16, s36, -v8
    v_fma_f32 v193, v17, s36, -v8
    ds_read2_b32 v[16:17], v97 offset0:0 offset1:16
    v_add_u32 v97, 0x80, v97
    s_waitcnt vmcnt(4)
    buffer_load_dwordx4 v[152:155], v5, s[24:27], s43 offen offset:0 nt
    buffer_load_dwordx4 v[156:159], v4, s[24:27], s43 offen offset:384 nt
    v_exp_f32 v192, v192
    v_exp_f32 v193, v193
    v_mov_b32 v176, v132
    v_mov_b32 v177, v133
    v_mov_b32 v178, v134
    v_mov_b32 v179, v135
    s_waitcnt vmcnt(5)
    v_cvt_pk_bf16_f32 v14, v192, v193
    v_add_f32 v9, v9, v192
    v_add_f32 v9, v9, v193
    v_mov_b32 v180, v136
    v_mov_b32 v181, v137
    v_mov_b32 v182, v138
    v_mov_b32 v183, v139
    s_waitcnt vmcnt(4)
    buffer_load_dwordx4 v[160:163], v5, s[24:27], s43 offen offset:256 nt
    v_and_b32 v28, v24, v14
    v_and_b32 v29, v25, v14
    v_and_b32 v30, v26, v14
    v_and_b32 v31, v27, v14
    v_mov_b32 v184, v140
    v_mov_b32 v185, v141
    v_mov_b32 v186, v142
    v_mov_b32 v187, v143
    s_waitcnt vmcnt(4)
    buffer_load_dwordx4 v[132:135], v4, s[24:27], s44 offen offset:0 nt
    v_mov_b32 v188, v144
    v_mov_b32 v189, v145
    v_mov_b32 v190, v146
    v_mov_b32 v191, v147
    s_waitcnt vmcnt(4)
    buffer_load_dwordx4 v[136:139], v5, s[24:27], s44 offen offset:128 nt
    buffer_load_dwordx4 v[140:143], v4, s[24:27], s44 offen offset:256 nt
    v_perm_b32 v56, v180, v148, s37
    v_perm_b32 v57, v180, v148, s38
    v_perm_b32 v58, v181, v149, s37
    v_perm_b32 v59, v181, v149, s38
    v_mfma_f32_16x16x16_bf16 v[208:211], v[28:29], v[56:57], v[208:211]
    v_perm_b32 v60, v182, v150, s37
    v_perm_b32 v61, v182, v150, s38
    v_mfma_f32_16x16x16_bf16 v[208:211], v[30:31], v[58:59], v[208:211]
    v_perm_b32 v62, v183, v151, s37
    v_perm_b32 v63, v183, v151, s38
    v_mfma_f32_16x16x16_bf16 v[212:215], v[28:29], v[60:61], v[212:215]
    s_nop 0
    v_mfma_f32_16x16x16_bf16 v[212:215], v[30:31], v[62:63], v[212:215]
    s_waitcnt vmcnt(5)
    v_perm_b32 v64, v152, v176, s37
    v_perm_b32 v65, v152, v176, s38
    v_perm_b32 v66, v153, v177, s37
    v_perm_b32 v67, v153, v177, s38
    v_mfma_f32_16x16x16_bf16 v[200:203], v[28:29], v[64:65], v[200:203]
    v_perm_b32 v68, v154, v178, s37
    v_perm_b32 v69, v154, v178, s38
    v_mfma_f32_16x16x16_bf16 v[200:203], v[30:31], v[66:67], v[200:203]
    v_perm_b32 v70, v155, v179, s37
    v_perm_b32 v71, v155, v179, s38
    v_mfma_f32_16x16x16_bf16 v[204:207], v[28:29], v[68:69], v[204:207]
    s_nop 0
    v_mfma_f32_16x16x16_bf16 v[204:207], v[30:31], v[70:71], v[204:207]
    s_waitcnt vmcnt(4)
    buffer_load_dwordx4 v[144:147], v5, s[24:27], s44 offen offset:384 nt
    v_perm_b32 v56, v188, v156, s37
    v_perm_b32 v57, v188, v156, s38
    v_perm_b32 v58, v189, v157, s37
    v_perm_b32 v59, v189, v157, s38
    v_mfma_f32_16x16x16_bf16 v[224:227], v[28:29], v[56:57], v[224:227]
    v_perm_b32 v60, v190, v158, s37
    v_perm_b32 v61, v190, v158, s38
    v_mfma_f32_16x16x16_bf16 v[224:227], v[30:31], v[58:59], v[224:227]
    v_perm_b32 v62, v191, v159, s37
    v_perm_b32 v63, v191, v159, s38
    v_mfma_f32_16x16x16_bf16 v[228:231], v[28:29], v[60:61], v[228:231]
    s_nop 0
    v_mfma_f32_16x16x16_bf16 v[228:231], v[30:31], v[62:63], v[228:231]
    s_waitcnt vmcnt(4)
    buffer_load_dwordx4 v[148:151], v4, s[24:27], s44 offen offset:128 nt
    v_perm_b32 v64, v160, v184, s37
    v_perm_b32 v65, v160, v184, s38
    v_perm_b32 v66, v161, v185, s37
    v_perm_b32 v67, v161, v185, s38
    v_mfma_f32_16x16x16_bf16 v[216:219], v[28:29], v[64:65], v[216:219]
    v_perm_b32 v68, v162, v186, s37
    v_perm_b32 v69, v162, v186, s38
    v_mfma_f32_16x16x16_bf16 v[216:219], v[30:31], v[66:67], v[216:219]
    v_perm_b32 v70, v163, v187, s37
    v_perm_b32 v71, v163, v187, s38
    v_mfma_f32_16x16x16_bf16 v[220:223], v[28:29], v[68:69], v[220:223]
    s_nop 0
    v_mfma_f32_16x16x16_bf16 v[220:223], v[30:31], v[70:71], v[220:223]
    s_mov_b32 s43, s44
    s_sub_u32 s33, s33, 1
    s_cmp_lg_u32 s33, 1
    s_cbranch_scc1 L_vloop
L_vpen:
    buffer_load_dwordx4 v[152:155], v5, s[24:27], s43 offen offset:0 nt
    buffer_load_dwordx4 v[156:159], v4, s[24:27], s43 offen offset:384 nt
    buffer_load_dwordx4 v[160:163], v5, s[24:27], s43 offen offset:256 nt
    buffer_load_dwordx4 v[232:235], v170, s[24:27], 0 offen offset:0 nt
    buffer_load_dwordx4 v[236:239], v171, s[24:27], 0 offen offset:128 nt
    buffer_load_dwordx4 v[240:243], v170, s[24:27], 0 offen offset:256 nt
    buffer_load_dwordx4 v[244:247], v171, s[24:27], 0 offen offset:384 nt
    buffer_load_dwordx4 v[248:251], v170, s[24:27], 0 offen offset:128 nt
    buffer_load_dwordx4 v[252:255], v171, s[24:27], 0 offen offset:0 nt
    buffer_load_dwordx4 v[32:35], v170, s[24:27], 0 offen offset:384 nt
    buffer_load_dwordx4 v[36:39], v171, s[24:27], 0 offen offset:256 nt
    s_waitcnt lgkmcnt(0)
    v_fma_f32 v192, v16, s36, -v8
    v_fma_f32 v193, v17, s36, -v8
    ds_read2_b32 v[16:17], v97 offset0:0 offset1:16
    v_exp_f32 v192, v192
    v_exp_f32 v193, v193
    s_nop 0
    v_cvt_pk_bf16_f32 v14, v192, v193
    v_add_f32 v9, v9, v192
    v_add_f32 v9, v9, v193
    v_and_b32 v176, v24, v14
    v_and_b32 v177, v25, v14
    v_and_b32 v178, v26, v14
    v_and_b32 v179, v27, v14
L_vlast:
    v_lshlrev_b32 v92, 4, v1
    s_lshl_b32 s40, s29, 12
    v_lshrrev_b32 v6, 5, v1
    v_lshl_add_u32 v90, v6, 11, s40
    v_lshl_add_u32 v90, v13, 6, v90
    v_bfe_u32 v6, v1, 4, 1
    v_lshl_add_u32 v90, v6, 4, v90
    s_lshl_b32 s40, s29, 4
    v_lshl_add_u32 v91, v15, 3, s40
    s_lshl_b32 s40, s30, 17
    s_add_u32 s46, s18, s40
    s_addc_u32 s47, s19, 0
    s_lshl_b32 s40, s31, 7
    s_lshl_b32 s41, s29, 15
    s_add_u32 s40, s40, s41
    v_lshl_add_u32 v93, v12, 12, s40
    v_lshl_add_u32 v93, v13, 4, v93
    s_lshl_b32 s40, s29, 9
    v_lshl_add_u32 v94, v1, 3, s40
    v_and_b32 v6, 1, v1
    v_lshlrev_b32 v95, 3, v6
    s_and_b32 s40, s31, 7
    s_lshl_b32 s40, s40, 2
    s_add_u32 s40, s40, s29
    s_lshl_b32 s41, s40, 12
    s_add_u32 s48, s46, s41
    s_addc_u32 s49, s47, 0
    s_lshl_b32 s41, s40, 4
    s_add_u32 s42, s42, s41
    v_lshrrev_b32 v13, 1, v13
    v_lshl_add_u32 v98, v13, 2, s42
    v_lshl_add_u32 v98, v6, 9, v98
    s_waitcnt lgkmcnt(0)
    v_fma_f32 v192, v16, s36, -v8
    v_fma_f32 v193, v17, s36, -v8
    v_exp_f32 v192, v192
    v_exp_f32 v193, v193
    s_nop 0
    v_cvt_pk_bf16_f32 v14, v192, v193
    v_add_f32 v9, v9, v192
    v_add_f32 v9, v9, v193
    v_and_b32 v28, v24, v14
    v_and_b32 v29, v25, v14
    v_and_b32 v30, v26, v14
    v_and_b32 v31, v27, v14
    v_mov_b32 v11, v9
    s_mov_b32 s56, 0x00ff00ff
    s_mov_b32 s57, 0xff00ff00
    v_permlane32_swap_b32 v9, v11
    v_add_f32 v9, v9, v11
    v_mov_b32 v11, v9
    s_nop 1
    v_permlane16_swap_b32 v9, v11
    v_add_f32 v9, v9, v11
    s_nop 1
    v_add_f32_dpp v9, v9, v9 row_ror:8 row_mask:0xf bank_mask:0xf
    ds_write_b64 v91, v[8:9] offset:16384
    s_waitcnt lgkmcnt(0)
    s_cmp_lg_u32 s53, 0
    s_cbranch_scc1 L_havenonce
    s_mov_b64 exec, 1
    global_atomic_cmpswap_x2 v[10:11], v99, v[164:167], s[16:17] sc0
    s_mov_b64 exec, -1
    s_waitcnt vmcnt(0)
    v_readfirstlane_b32 s52, v10
    v_readfirstlane_b32 s53, v11
    s_cmp_lg_u32 s53, 0
    s_cselect_b32 s52, s52, s50
    s_cselect_b32 s53, s53, s51
L_havenonce:
    s_barrier
    ds_read_b64 v[40:41], v95 offset:16384
    ds_read_b64 v[42:43], v95 offset:16400
    ds_read_b64 v[44:45], v95 offset:16416
    ds_read_b64 v[46:47], v95 offset:16432
    s_waitcnt lgkmcnt(0)
    v_max3_f32 v48, v40, v42, v44
    v_max_f32 v48, v48, v46
    v_sub_f32 v40, v40, v48
    v_sub_f32 v42, v42, v48
    v_sub_f32 v44, v44, v48
    v_sub_f32 v46, v46, v48
    v_exp_f32 v40, v40
    v_exp_f32 v42, v42
    v_exp_f32 v44, v44
    v_exp_f32 v46, v46
    v_mul_f32 v49, v40, v41
    v_fmac_f32 v49, v42, v43
    v_fmac_f32 v49, v44, v45
    v_fmac_f32 v49, v46, v47
    v_max_f32 v49, 0x0da24260, v49
    v_log_f32 v50, v49
    v_rcp_f32 v49, v49
    v_add_f32 v50, v50, v48
    v_xor_b32 v165, s52, v50
    v_xor_b32 v167, s53, v50
    v_mul_f32 v40, v40, v49
    v_mul_f32 v42, v42, v49
    v_mul_f32 v44, v44, v49
    v_mul_f32 v46, v46, v49
    s_waitcnt vmcnt(11)
    v_perm_b32 v56, v136, v148, s37
    v_perm_b32 v57, v136, v148, s38
    v_perm_b32 v58, v137, v149, s37
    v_perm_b32 v59, v137, v149, s38
    v_mfma_f32_16x16x16_bf16 v[208:211], v[176:177], v[56:57], v[208:211]
    v_perm_b32 v60, v138, v150, s37
    v_perm_b32 v61, v138, v150, s38
    v_mfma_f32_16x16x16_bf16 v[208:211], v[178:179], v[58:59], v[208:211]
    v_perm_b32 v62, v139, v151, s37
    v_perm_b32 v63, v139, v151, s38
    v_mfma_f32_16x16x16_bf16 v[212:215], v[176:177], v[60:61], v[212:215]
    s_nop 0
    v_mfma_f32_16x16x16_bf16 v[212:215], v[178:179], v[62:63], v[212:215]
    s_waitcnt vmcnt(10)
    v_perm_b32 v64, v152, v132, s37
    v_perm_b32 v65, v152, v132, s38
    v_perm_b32 v66, v153, v133, s37
    v_perm_b32 v67, v153, v133, s38
    v_mfma_f32_16x16x16_bf16 v[200:203], v[176:177], v[64:65], v[200:203]
    v_perm_b32 v68, v154, v134, s37
    v_perm_b32 v69, v154, v134, s38
    v_mfma_f32_16x16x16_bf16 v[200:203], v[178:179], v[66:67], v[200:203]
    v_perm_b32 v70, v155, v135, s37
    v_perm_b32 v71, v155, v135, s38
    v_mfma_f32_16x16x16_bf16 v[204:207], v[176:177], v[68:69], v[204:207]
    s_nop 0
    v_mfma_f32_16x16x16_bf16 v[204:207], v[178:179], v[70:71], v[204:207]
    s_waitcnt vmcnt(9)
    v_perm_b32 v56, v144, v156, s37
    v_perm_b32 v57, v144, v156, s38
    v_perm_b32 v58, v145, v157, s37
    v_perm_b32 v59, v145, v157, s38
    v_mfma_f32_16x16x16_bf16 v[224:227], v[176:177], v[56:57], v[224:227]
    v_perm_b32 v60, v146, v158, s37
    v_perm_b32 v61, v146, v158, s38
    v_mfma_f32_16x16x16_bf16 v[224:227], v[178:179], v[58:59], v[224:227]
    v_perm_b32 v62, v147, v159, s37
    v_perm_b32 v63, v147, v159, s38
    v_mfma_f32_16x16x16_bf16 v[228:231], v[176:177], v[60:61], v[228:231]
    s_nop 0
    v_mfma_f32_16x16x16_bf16 v[228:231], v[178:179], v[62:63], v[228:231]
    s_waitcnt vmcnt(8)
    v_perm_b32 v64, v160, v140, s37
    v_perm_b32 v65, v160, v140, s38
    v_perm_b32 v66, v161, v141, s37
    v_perm_b32 v67, v161, v141, s38
    v_mfma_f32_16x16x16_bf16 v[216:219], v[176:177], v[64:65], v[216:219]
    v_perm_b32 v68, v162, v142, s37
    v_perm_b32 v69, v162, v142, s38
    v_mfma_f32_16x16x16_bf16 v[216:219], v[178:179], v[66:67], v[216:219]
    v_perm_b32 v70, v163, v143, s37
    v_perm_b32 v71, v163, v143, s38
    v_mfma_f32_16x16x16_bf16 v[220:223], v[176:177], v[68:69], v[220:223]
    s_nop 0
    v_mfma_f32_16x16x16_bf16 v[220:223], v[178:179], v[70:71], v[220:223]
    s_waitcnt vmcnt(3)
    v_perm_b32 v56, v236, v248, s37
    v_perm_b32 v57, v236, v248, s38
    v_perm_b32 v58, v237, v249, s37
    v_perm_b32 v59, v237, v249, s38
    v_mfma_f32_16x16x16_bf16 v[208:211], v[28:29], v[56:57], v[208:211]
    v_perm_b32 v60, v238, v250, s37
    v_perm_b32 v61, v238, v250, s38
    v_mfma_f32_16x16x16_bf16 v[208:211], v[30:31], v[58:59], v[208:211]
    v_perm_b32 v62, v239, v251, s37
    v_perm_b32 v63, v239, v251, s38
    v_mfma_f32_16x16x16_bf16 v[212:215], v[28:29], v[60:61], v[212:215]
    s_nop 0
    v_mfma_f32_16x16x16_bf16 v[212:215], v[30:31], v[62:63], v[212:215]
    s_waitcnt vmcnt(2)
    v_perm_b32 v64, v252, v232, s37
    v_perm_b32 v65, v252, v232, s38
    v_perm_b32 v66, v253, v233, s37
    v_perm_b32 v67, v253, v233, s38
    v_mfma_f32_16x16x16_bf16 v[200:203], v[28:29], v[64:65], v[200:203]
    v_perm_b32 v68, v254, v234, s37
    v_perm_b32 v69, v254, v234, s38
    v_mfma_f32_16x16x16_bf16 v[200:203], v[30:31], v[66:67], v[200:203]
    v_perm_b32 v70, v255, v235, s37
    v_perm_b32 v71, v255, v235, s38
    v_mfma_f32_16x16x16_bf16 v[204:207], v[28:29], v[68:69], v[204:207]
    s_nop 0
    v_mfma_f32_16x16x16_bf16 v[204:207], v[30:31], v[70:71], v[204:207]
    s_mov_b64 exec, s[56:57]
    ds_write_b128 v90, v[208:211] offset:512
    ds_write_b128 v90, v[212:215] offset:544
    s_mov_b64 exec, -1
    s_waitcnt vmcnt(1)
    v_perm_b32 v56, v244, v32, s37
    v_perm_b32 v57, v244, v32, s38
    v_perm_b32 v58, v245, v33, s37
    v_perm_b32 v59, v245, v33, s38
    v_mfma_f32_16x16x16_bf16 v[224:227], v[28:29], v[56:57], v[224:227]
    v_perm_b32 v60, v246, v34, s37
    v_perm_b32 v61, v246, v34, s38
    v_mfma_f32_16x16x16_bf16 v[224:227], v[30:31], v[58:59], v[224:227]
    v_perm_b32 v62, v247, v35, s37
    v_perm_b32 v63, v247, v35, s38
    v_mfma_f32_16x16x16_bf16 v[228:231], v[28:29], v[60:61], v[228:231]
    s_nop 0
    v_mfma_f32_16x16x16_bf16 v[228:231], v[30:31], v[62:63], v[228:231]
    s_mov_b64 exec, s[56:57]
    ds_write_b128 v90, v[200:203] offset:0
    ds_write_b128 v90, v[204:207] offset:32
    s_mov_b64 exec, -1
    s_waitcnt vmcnt(0)
    v_perm_b32 v64, v36, v240, s37
    v_perm_b32 v65, v36, v240, s38
    v_perm_b32 v66, v37, v241, s37
    v_perm_b32 v67, v37, v241, s38
    v_mfma_f32_16x16x16_bf16 v[216:219], v[28:29], v[64:65], v[216:219]
    v_perm_b32 v68, v38, v242, s37
    v_perm_b32 v69, v38, v242, s38
    v_mfma_f32_16x16x16_bf16 v[216:219], v[30:31], v[66:67], v[216:219]
    v_perm_b32 v70, v39, v243, s37
    v_perm_b32 v71, v39, v243, s38
    v_mfma_f32_16x16x16_bf16 v[220:223], v[28:29], v[68:69], v[220:223]
    s_nop 0
    v_mfma_f32_16x16x16_bf16 v[220:223], v[30:31], v[70:71], v[220:223]
    s_mov_b64 exec, s[56:57]
    ds_write_b128 v90, v[224:227] offset:1536
    ds_write_b128 v90, v[228:231] offset:1568
    s_nop 2
    ds_write_b128 v90, v[216:219] offset:1024
    s_nop 0
    ds_write_b128 v90, v[220:223] offset:1056
    s_mov_b64 exec, -1
    s_cmp_lt_u32 s31, 24
    s_waitcnt lgkmcnt(0)
    s_barrier
    ds_read2st64_b64 v[100:103], v94 offset0:0 offset1:4
    ds_read2st64_b64 v[104:107], v94 offset0:8 offset1:12
    ds_read2st64_b64 v[108:111], v94 offset0:16 offset1:20
    ds_read2st64_b64 v[112:115], v94 offset0:24 offset1:28
    s_waitcnt lgkmcnt(3)
    v_mul_f32 v164, v40, v100
    v_mul_f32 v166, v40, v101
    v_fmac_f32 v164, v40, v102
    v_fmac_f32 v166, v40, v103
    s_waitcnt lgkmcnt(2)
    v_fmac_f32 v164, v42, v104
    v_fmac_f32 v166, v42, v105
    v_fmac_f32 v164, v42, v106
    v_fmac_f32 v166, v42, v107
    s_waitcnt lgkmcnt(1)
    v_fmac_f32 v164, v44, v108
    v_fmac_f32 v166, v44, v109
    v_fmac_f32 v164, v44, v110
    v_fmac_f32 v166, v44, v111
    s_waitcnt lgkmcnt(0)
    v_fmac_f32 v164, v46, v112
    v_fmac_f32 v166, v46, v113
    v_fmac_f32 v164, v46, v114
    v_fmac_f32 v166, v46, v115
    global_store_dwordx4 v93, v[164:167], s[46:47] sc1
    s_cbranch_scc1 L_fin
    s_xor_b32 s53, s53, s52
    s_mov_b64 s[90:91], -1
    s_mov_b64 s[92:93], -1
    s_mov_b64 s[94:95], -1
    s_mov_b64 s[96:97], -1
    s_waitcnt vmcnt(0)
L_poll:
    s_mov_b64 exec, s[90:91]
    global_load_dwordx4 v[132:135], v92, s[48:49] offset:0 sc1
    s_mov_b64 exec, s[92:93]
    global_load_dwordx4 v[136:139], v92, s[48:49] offset:1024 sc1
    s_mov_b64 exec, s[94:95]
    global_load_dwordx4 v[140:143], v92, s[48:49] offset:2048 sc1
    s_mov_b64 exec, s[96:97]
    global_load_dwordx4 v[144:147], v92, s[48:49] offset:3072 sc1
    s_mov_b64 exec, -1
    s_waitcnt vmcnt(0)
    v_xor_b32 v152, v133, v135
    v_xor_b32 v153, v137, v139
    v_xor_b32 v154, v141, v143
    v_xor_b32 v155, v145, v147
    v_xor_b32_dpp v156, v133, v133 quad_perm:[2,3,0,1] row_mask:0xf bank_mask:0xf
    v_xor_b32_dpp v157, v137, v137 quad_perm:[2,3,0,1] row_mask:0xf bank_mask:0xf
    v_xor_b32_dpp v158, v141, v141 quad_perm:[2,3,0,1] row_mask:0xf bank_mask:0xf
    v_xor_b32_dpp v159, v145, v145 quad_perm:[2,3,0,1] row_mask:0xf bank_mask:0xf
    v_xor_b32 v152, s53, v152
    v_xor_b32 v153, s53, v153
    v_xor_b32 v154, s53, v154
    v_xor_b32 v155, s53, v155
    v_or_b32 v152, v152, v156
    v_or_b32 v153, v153, v157
    v_or_b32 v154, v154, v158
    v_or_b32 v155, v155, v159
    v_or_b32_dpp v152, v152, v152 quad_perm:[1,0,3,2] row_mask:0xf bank_mask:0xf
    v_or_b32_dpp v153, v153, v153 quad_perm:[1,0,3,2] row_mask:0xf bank_mask:0xf
    v_or_b32_dpp v154, v154, v154 quad_perm:[1,0,3,2] row_mask:0xf bank_mask:0xf
    v_or_b32_dpp v155, v155, v155 quad_perm:[1,0,3,2] row_mask:0xf bank_mask:0xf
    v_or_b32_dpp v152, v152, v152 quad_perm:[2,3,0,1] row_mask:0xf bank_mask:0xf
    v_or_b32_dpp v153, v153, v153 quad_perm:[2,3,0,1] row_mask:0xf bank_mask:0xf
    v_or_b32_dpp v154, v154, v154 quad_perm:[2,3,0,1] row_mask:0xf bank_mask:0xf
    v_or_b32_dpp v155, v155, v155 quad_perm:[2,3,0,1] row_mask:0xf bank_mask:0xf
    v_or_b32_dpp v152, v152, v152 row_half_mirror row_mask:0xf bank_mask:0xf
    v_or_b32_dpp v153, v153, v153 row_half_mirror row_mask:0xf bank_mask:0xf
    v_or_b32_dpp v154, v154, v154 row_half_mirror row_mask:0xf bank_mask:0xf
    v_or_b32_dpp v155, v155, v155 row_half_mirror row_mask:0xf bank_mask:0xf
    v_cmp_ne_u32 s[90:91], 0, v152
    v_cmp_ne_u32 s[92:93], 0, v153
    v_cmp_ne_u32 s[94:95], 0, v154
    v_cmp_ne_u32 s[96:97], 0, v155
    v_xor_b32 v148, s52, v133
    v_xor_b32 v149, s52, v137
    v_xor_b32 v150, s52, v141
    v_xor_b32 v151, s52, v145
    s_or_b64 s[40:41], s[90:91], s[92:93]
    s_or_b64 s[42:43], s[94:95], s[96:97]
    s_or_b64 s[44:45], s[40:41], s[42:43]
    s_cbranch_scc0 L_go
    s_bcnt1_i32_b64 s40, s[40:41]
    s_bcnt1_i32_b64 s41, s[42:43]
    s_add_u32 s40, s40, s41
    s_cmp_le_u32 s40, 32
    s_cbranch_scc1 L_poll
    s_sleep 6
    s_branch L_poll
L_go:
    v_max3_f32 v56, v148, v149, v150
    v_max_f32 v56, v56, v151
    v_mov_b32 v58, v56
    s_nop 1
    v_permlane32_swap_b32 v56, v58
    v_max_f32 v56, v56, v58
    v_mov_b32 v58, v56
    s_nop 1
    v_permlane16_swap_b32 v56, v58
    v_max_f32 v56, v56, v58
    s_nop 1
    v_max_f32_dpp v56, v56, v56 row_ror:8 row_mask:0xf bank_mask:0xf
    v_sub_f32 v148, v148, v56
    v_sub_f32 v149, v149, v56
    v_sub_f32 v150, v150, v56
    v_sub_f32 v151, v151, v56
    v_exp_f32 v148, v148
    v_exp_f32 v149, v149
    v_exp_f32 v150, v150
    v_exp_f32 v151, v151
    v_mul_f32 v132, v148, v132
    v_mul_f32 v134, v148, v134
    v_add_f32 v57, v148, v149
    v_add_f32 v58, v150, v151
    v_add_f32 v57, v57, v58
    v_fmac_f32 v132, v149, v136
    v_fmac_f32 v134, v149, v138
    v_fmac_f32 v132, v150, v140
    v_fmac_f32 v134, v150, v142
    v_fmac_f32 v132, v151, v144
    v_fmac_f32 v134, v151, v146
    v_mov_b32 v58, v57
    v_mov_b32 v133, v132
    v_mov_b32 v135, v134
    v_permlane32_swap_b32 v57, v58
    v_permlane32_swap_b32 v132, v133
    v_permlane32_swap_b32 v134, v135
    v_add_f32 v57, v57, v58
    v_add_f32 v132, v132, v133
    v_add_f32 v134, v134, v135
    v_mov_b32 v58, v57
    v_mov_b32 v133, v132
    v_mov_b32 v135, v134
    v_permlane16_swap_b32 v57, v58
    v_permlane16_swap_b32 v132, v133
    v_permlane16_swap_b32 v134, v135
    v_add_f32 v57, v57, v58
    v_add_f32 v132, v132, v133
    v_add_f32 v134, v134, v135
    v_add_f32_dpp v57, v57, v57 row_ror:8 row_mask:0xf bank_mask:0xf
    v_add_f32_dpp v132, v132, v132 row_ror:8 row_mask:0xf bank_mask:0xf
    v_add_f32_dpp v134, v134, v134 row_ror:8 row_mask:0xf bank_mask:0xf
    v_rcp_f32 v57, v57
    s_mov_b64 exec, 0xff
    v_mul_f32 v132, v132, v57
    v_mul_f32 v134, v134, v57
    v_cvt_pk_bf16_f32 v132, v132, v134
    global_store_dword v98, v132, s[14:15]
L_fin:
L_end:
    s_endpgm
.section .rodata,"a"
.p2align 6
.amdhsa_kernel standalone__paged_block_table_kv_pagedattention__decode_kernel
  .amdhsa_next_free_vgpr 512
  .amdhsa_next_free_sgpr 102
  .amdhsa_accum_offset 256
  .amdhsa_group_segment_fixed_size 0
  .amdhsa_kernarg_size 64
  .amdhsa_user_sgpr_count 2
  .amdhsa_user_sgpr_kernarg_segment_ptr 1
  .amdhsa_system_sgpr_workgroup_id_x 1
.end_amdhsa_kernel
```
